```python
import torch

def _softmax(x, axis=-1):
    return torch.softmax(x, dim=axis)
def _gelu(x):
    return torch.nn.functional.gelu(x, approximate="tanh")
def _silu(x):
    return torch.nn.functional.silu(x)
def _sigmoid(x):
    return torch.sigmoid(x)
def _layernorm(x, axis=-1, eps=1e-5):
    m = x.mean(dim=axis, keepdim=True)
    v = x.var(dim=axis, keepdim=True, unbiased=False)
    return (x - m) / torch.sqrt(v + eps)
def _scatter_add(tgt, idx, src, axis=0):
    return tgt.clone().index_add_(axis, idx, src)
def _segment_sum(src, seg, n):
    out = torch.zeros((n,) + src.shape[1:], dtype=src.dtype)
    return out.index_add_(0, seg, src)
def _pad(x, pw):
    flat = tuple(v for pair in reversed(pw) for v in pair)
    return torch.nn.functional.pad(x, flat)

kernel_name = 'standalone__fm_second_order__recsys'

def setup_inputs():

    _w = (lambda a: (lambda t: t.to(torch.bfloat16) if t.is_floating_point() else t)(torch.as_tensor(a)))
    B, F, D, V = 16384, 26, 128, min(100000, 100000)
    return {
        "idx": _w((lambda lo, hi, *s: torch.randint(lo, hi, s))(0, V, B, F).to(torch.int64)),
        "table": _w((lambda *s: torch.randn(*s, dtype=torch.bfloat16) * 0.05)(V, D)),
    }

def reference(idx, table):
    emb = table[idx]
    sum_sq = emb.sum(axis=1) ** 2
    sq_sum = (emb ** 2).sum(axis=1)
    return 0.5 * (sum_sq - sq_sum).sum(axis=-1)
```

```asm
; @launch grid=(256,1,1) block=(256,1,1) lds=20480
.amdgcn_target "amdgcn-amd-amdhsa--gfx950"
.text
.globl standalone__fm_second_order__recsys_kernel
.p2align 8
.type standalone__fm_second_order__recsys_kernel,@function
standalone__fm_second_order__recsys_kernel:
    s_cmp_ge_u32 s2, 256
    s_cbranch_scc1 L_done
    s_load_dwordx4 s[4:7], s[0:1], 0
    s_load_dwordx4 s[16:19], s[0:1], 16
    s_load_dwordx2 s[20:21], s[0:1], 32
    v_readfirstlane_b32 s3, v0
    v_and_b32 v0, 63, v0
    v_mov_b32 v63, 0
    s_lshr_b32 s3, s3, 6
    v_mul_u32_u24 v2, 52, v0
    s_lshr_b32 s24, s2, 3
    s_lshl_b32 s24, s24, 2
    s_and_b32 s27, s2, 3
    s_or_b32 s24, s24, s27
    s_bfe_u32 s27, s2, 0x10002
    s_lshl_b32 s25, s24, 2
    s_add_u32 s25, s25, s3
    s_mul_i32 s26, s25, 3328
    s_lshl_b32 s27, s27, 7
    s_mov_b32 s10, 1703936
    s_mov_b32 s11, 0x00020000
    s_mov_b32 s14, 25600000
    s_mov_b32 s15, 0x00020000
    s_mov_b32 s38, 256
    s_mov_b32 s39, 0x00020000
    s_or_b32 s28, s2, s3
    s_mul_i32 s29, s3, 5120
    s_waitcnt lgkmcnt(0)
    s_mov_b32 s8, s4
    s_and_b32 s9, s5, 0xffff
    buffer_load_dwordx4 v[48:51], v2, s[8:11], s26 offen
    buffer_load_dwordx4 v[52:55], v2, s[8:11], s26 offen offset:16
    buffer_load_dwordx4 v[56:59], v2, s[8:11], s26 offen offset:32
    buffer_load_dword   v60, v2, s[8:11], s26 offen offset:48
    s_mov_b32 s12, s6
    s_and_b32 s13, s7, 0xffff
    s_mov_b32 s36, s18
    s_and_b32 s37, s19, 0xffff
    s_cmp_lg_u32 s28, 0
    s_cbranch_scc1 L_nowrite
    s_memrealtime s[40:41]
    s_waitcnt lgkmcnt(0)
    s_or_b32 s40, s40, 1
    v_mov_b32 v62, s40
    s_mov_b64 exec, 1
    buffer_atomic_cmpswap v[62:63], v63, s[36:39], 0 offen
    s_mov_b64 exec, -1
L_nowrite:
    v_lshrrev_b32 v3, 5, v0
    v_lshrrev_b32 v4, 3, v0
    v_xor_b32 v3, v3, v4
    v_and_b32 v3, 1, v3
    v_lshlrev_b32 v3, 2, v3
    v_bfe_u32 v4, v0, 1, 2
    v_or_b32 v3, v3, v4
    v_and_b32 v4, 1, v0
    v_lshlrev_b32 v4, 4, v4
    v_mov_b32 v5, 0x3f80
    v_lshlrev_b32 v1, v4, v5
    v_cmp_eq_u32 vcc, 0, v3
    v_cmp_eq_u32 s[30:31], 1, v3
    v_cmp_eq_u32 s[32:33], 2, v3
    v_cmp_eq_u32 s[34:35], 3, v3
    v_mov_b32 v2, 80
    v_cndmask_b32 v4, 0, v1, vcc
    v_cndmask_b32 v5, 0, v1, s[30:31]
    v_cndmask_b32 v6, 0, v1, s[32:33]
    v_cndmask_b32 v7, 0, v1, s[34:35]
    v_mad_u32_u24 v2, v0, v2, s29
    v_bfe_u32 v1, v0, 3, 1
    v_bfe_u32 v3, v0, 4, 1
    v_lshl_add_u32 v1, v1, 1, v3
    v_bfe_u32 v3, v0, 5, 1
    v_lshl_add_u32 v1, v3, 2, v1
    v_mul_u32_u24 v3, 80, v1
    v_add_u32 v3, s29, v3
    v_and_b32 v1, 7, v0
    v_lshlrev_b32 v1, 4, v1
    v_mov_b32 v8, 0
    v_mov_b32 v9, 0
    v_mov_b32 v10, 0
    v_mov_b32 v11, 0
    v_mov_b32 v12, 0
    v_mov_b32 v13, 0
    v_mov_b32 v14, 0
    v_mov_b32 v15, 0
    v_mov_b32 v16, 0
    v_mov_b32 v17, 0
    v_mov_b32 v18, 0
    v_mov_b32 v19, 0
    v_mov_b32 v20, 0
    v_mov_b32 v21, 0
    v_mov_b32 v22, 0
    v_mov_b32 v23, 0
    v_mov_b32 v24, 0
    v_mov_b32 v25, 0
    v_mov_b32 v26, 0
    v_mov_b32 v27, 0
    v_mov_b32 v28, 0
    v_mov_b32 v29, 0
    v_mov_b32 v30, 0
    v_mov_b32 v31, 0
    v_mov_b32 v32, 0
    v_mov_b32 v33, 0
    v_mov_b32 v34, 0
    v_mov_b32 v35, 0
    v_mov_b32 v36, 0
    v_mov_b32 v37, 0
    v_mov_b32 v38, 0
    v_mov_b32 v39, 0
    v_mov_b32 v40, 0
    v_mov_b32 v41, 0
    v_mov_b32 v42, 0
    v_mov_b32 v43, 0
    v_mov_b32 v44, 0
    v_mov_b32 v45, 0
    v_mov_b32 v46, 0
    v_mov_b32 v47, 0
    s_waitcnt vmcnt(0)
    v_min3_u32 v142, v48, v49, v50
    v_min3_u32 v142, v142, v51, v52
    v_min3_u32 v142, v142, v53, v54
    v_min3_u32 v142, v142, v55, v56
    v_min3_u32 v142, v142, v57, v58
    v_min3_u32 v142, v142, v59, v60
    ds_write_b32 v2, v142 offset:64
    v_min_u32 v61, v48, v60
    v_max_u32 v60, v48, v60
    v_min_u32 v48, v49, v58
    v_max_u32 v58, v49, v58
    v_min_u32 v49, v50, v57
    v_max_u32 v57, v50, v57
    v_min_u32 v50, v51, v55
    v_max_u32 v55, v51, v55
    s_waitcnt lgkmcnt(0)
    ds_read_b32 v160, v3 offset:64
    ds_read_b32 v161, v3 offset:704
    ds_read_b32 v162, v3 offset:1344
    ds_read_b32 v163, v3 offset:1984
    ds_read_b32 v164, v3 offset:2624
    ds_read_b32 v165, v3 offset:3264
    ds_read_b32 v166, v3 offset:3904
    ds_read_b32 v167, v3 offset:4544
    v_min_u32 v51, v53, v59
    v_max_u32 v59, v53, v59
    v_min_u32 v53, v54, v56
    v_max_u32 v56, v54, v56
    v_min_u32 v54, v48, v53
    v_max_u32 v53, v48, v53
    v_min_u32 v48, v49, v50
    v_max_u32 v50, v49, v50
    s_waitcnt lgkmcnt(7)
    v_lshl_add_u32 v168, v160, 8, v1
    buffer_load_dwordx4 v[168:171], v168, s[12:15], s27 offen
    s_waitcnt lgkmcnt(6)
    v_lshl_add_u32 v172, v161, 8, v1
    buffer_load_dwordx4 v[172:175], v172, s[12:15], s27 offen
    s_waitcnt lgkmcnt(5)
    v_lshl_add_u32 v176, v162, 8, v1
    buffer_load_dwordx4 v[176:179], v176, s[12:15], s27 offen
    s_waitcnt lgkmcnt(4)
    v_lshl_add_u32 v180, v163, 8, v1
    buffer_load_dwordx4 v[180:183], v180, s[12:15], s27 offen
    s_waitcnt lgkmcnt(3)
    v_lshl_add_u32 v184, v164, 8, v1
    buffer_load_dwordx4 v[184:187], v184, s[12:15], s27 offen
    s_waitcnt lgkmcnt(2)
    v_lshl_add_u32 v188, v165, 8, v1
    buffer_load_dwordx4 v[188:191], v188, s[12:15], s27 offen
    s_waitcnt lgkmcnt(1)
    v_lshl_add_u32 v192, v166, 8, v1
    buffer_load_dwordx4 v[192:195], v192, s[12:15], s27 offen
    s_waitcnt lgkmcnt(0)
    v_lshl_add_u32 v196, v167, 8, v1
    buffer_load_dwordx4 v[196:199], v196, s[12:15], s27 offen
    v_min_u32 v49, v52, v59
    v_max_u32 v59, v52, v59
    v_min_u32 v52, v55, v57
    v_max_u32 v57, v55, v57
    v_min_u32 v55, v56, v58
    v_max_u32 v58, v56, v58
    v_min_u32 v56, v61, v49
    v_max_u32 v49, v61, v49
    v_min_u32 v61, v54, v48
    v_max_u32 v48, v54, v48
    v_min_u32 v54, v50, v53
    v_max_u32 v53, v50, v53
    v_min_u32 v50, v52, v55
    v_max_u32 v55, v52, v55
    v_min_u32 v52, v57, v58
    v_max_u32 v58, v57, v58
    v_min_u32 v57, v59, v60
    v_max_u32 v60, v59, v60
    v_min_u32 v59, v49, v53
    v_max_u32 v53, v49, v53
    v_min_u32 v49, v51, v52
    v_max_u32 v52, v51, v52
    v_min_u32 v51, v55, v57
    v_max_u32 v57, v55, v57
    v_min_u32 v55, v58, v60
    v_max_u32 v140, v58, v60
    v_min_u32 v58, v56, v49
    v_max_u32 v49, v56, v49
    v_min_u32 v56, v54, v51
    v_max_u32 v51, v54, v51
    v_min_u32 v54, v59, v50
    v_max_u32 v50, v59, v50
    v_min_u32 v59, v53, v57
    v_max_u32 v57, v53, v57
    v_min_u32 v53, v52, v55
    v_max_u32 v55, v52, v55
    v_min_u32 v128, v58, v61
    v_max_u32 v61, v58, v61
    v_min_u32 v52, v48, v49
    v_max_u32 v49, v48, v49
    v_min_u32 v48, v59, v53
    v_max_u32 v53, v59, v53
    v_min_u32 v59, v50, v51
    v_max_u32 v51, v50, v51
    v_min_u32 v50, v55, v57
    v_max_u32 v139, v55, v57
    v_min_u32 v55, v61, v56
    v_max_u32 v56, v61, v56
    v_min_u32 v61, v52, v54
    v_max_u32 v54, v52, v54
    v_min_u32 v52, v49, v48
    v_max_u32 v48, v49, v48
    v_min_u32 v49, v53, v50
    v_max_u32 v138, v53, v50
    v_min_u32 v129, v55, v61
    v_max_u32 v61, v55, v61
    v_min_u32 v53, v56, v54
    v_max_u32 v54, v56, v54
    v_min_u32 v56, v52, v59
    v_max_u32 v59, v52, v59
    v_min_u32 v52, v48, v51
    v_max_u32 v51, v48, v51
    v_min_u32 v130, v61, v53
    v_max_u32 v53, v61, v53
    v_min_u32 v48, v54, v56
    v_max_u32 v56, v54, v56
    v_min_u32 v54, v52, v59
    v_max_u32 v135, v52, v59
    v_min_u32 v136, v51, v49
    v_max_u32 v137, v51, v49
    v_min_u32 v131, v53, v48
    v_max_u32 v132, v53, v48
    v_min_u32 v133, v56, v54
    v_max_u32 v134, v56, v54
    ds_write_b128 v2, v[128:131]
    ds_write_b128 v2, v[132:135] offset:16
    ds_write_b128 v2, v[136:139] offset:32
    ds_write_b32 v2, v140 offset:48
    s_waitcnt lgkmcnt(0)
    ds_read_b128 v[64:67], v3 offset:0
    ds_read_b128 v[68:71], v3 offset:640
    ds_read_b128 v[72:75], v3 offset:1280
    ds_read_b128 v[76:79], v3 offset:1920
    ds_read_b128 v[80:83], v3 offset:2560
    ds_read_b128 v[84:87], v3 offset:3200
    ds_read_b128 v[88:91], v3 offset:3840
    ds_read_b128 v[92:95], v3 offset:4480
    s_waitcnt lgkmcnt(7)
    v_lshl_add_u32 v200, v65, 8, v1
    buffer_load_dwordx4 v[200:203], v200, s[12:15], s27 offen
    s_waitcnt lgkmcnt(6)
    v_lshl_add_u32 v204, v69, 8, v1
    buffer_load_dwordx4 v[204:207], v204, s[12:15], s27 offen
    s_waitcnt lgkmcnt(5)
    v_lshl_add_u32 v208, v73, 8, v1
    buffer_load_dwordx4 v[208:211], v208, s[12:15], s27 offen
    s_waitcnt lgkmcnt(4)
    v_lshl_add_u32 v212, v77, 8, v1
    buffer_load_dwordx4 v[212:215], v212, s[12:15], s27 offen
    s_waitcnt vmcnt(11)
    v_mfma_f32_16x16x32_bf16 v[8:11], v[4:7], v[168:171], v[8:11]
    v_dot2c_f32_bf16 v40, v168, v168
    v_dot2c_f32_bf16 v40, v169, v169
    v_dot2c_f32_bf16 v40, v170, v170
    v_dot2c_f32_bf16 v40, v171, v171
    s_waitcnt lgkmcnt(3)
    v_lshl_add_u32 v168, v81, 8, v1
    buffer_load_dwordx4 v[168:171], v168, s[12:15], s27 offen
    s_waitcnt vmcnt(11)
    v_mfma_f32_16x16x32_bf16 v[12:15], v[4:7], v[172:175], v[12:15]
    v_dot2c_f32_bf16 v41, v172, v172
    v_dot2c_f32_bf16 v41, v173, v173
    v_dot2c_f32_bf16 v41, v174, v174
    v_dot2c_f32_bf16 v41, v175, v175
    s_waitcnt lgkmcnt(2)
    v_lshl_add_u32 v172, v85, 8, v1
    buffer_load_dwordx4 v[172:175], v172, s[12:15], s27 offen
    s_waitcnt vmcnt(11)
    v_mfma_f32_16x16x32_bf16 v[16:19], v[4:7], v[176:179], v[16:19]
    v_dot2c_f32_bf16 v42, v176, v176
    v_dot2c_f32_bf16 v42, v177, v177
    v_dot2c_f32_bf16 v42, v178, v178
    v_dot2c_f32_bf16 v42, v179, v179
    s_waitcnt lgkmcnt(1)
    v_lshl_add_u32 v176, v89, 8, v1
    buffer_load_dwordx4 v[176:179], v176, s[12:15], s27 offen
    s_waitcnt vmcnt(11)
    v_mfma_f32_16x16x32_bf16 v[20:23], v[4:7], v[180:183], v[20:23]
    v_dot2c_f32_bf16 v43, v180, v180
    v_dot2c_f32_bf16 v43, v181, v181
    v_dot2c_f32_bf16 v43, v182, v182
    v_dot2c_f32_bf16 v43, v183, v183
    s_waitcnt lgkmcnt(0)
    v_lshl_add_u32 v180, v93, 8, v1
    buffer_load_dwordx4 v[180:183], v180, s[12:15], s27 offen
    s_waitcnt vmcnt(11)
    v_mfma_f32_16x16x32_bf16 v[24:27], v[4:7], v[184:187], v[24:27]
    v_dot2c_f32_bf16 v44, v184, v184
    v_dot2c_f32_bf16 v44, v185, v185
    v_dot2c_f32_bf16 v44, v186, v186
    v_dot2c_f32_bf16 v44, v187, v187
    ds_read_b128 v[96:99], v3 offset:16
    ds_read_b128 v[100:103], v3 offset:656
    ds_read_b128 v[104:107], v3 offset:1296
    ds_read_b128 v[108:111], v3 offset:1936
    ds_read_b128 v[112:115], v3 offset:2576
    ds_read_b128 v[116:119], v3 offset:3216
    ds_read_b128 v[120:123], v3 offset:3856
    ds_read_b128 v[124:127], v3 offset:4496
    ds_read_b128 v[128:131], v3 offset:32
    ds_read_b128 v[132:135], v3 offset:672
    ds_read_b128 v[136:139], v3 offset:1312
    ds_read_b128 v[140:143], v3 offset:1952
    v_lshl_add_u32 v184, v66, 8, v1
    buffer_load_dwordx4 v[184:187], v184, s[12:15], s27 offen
    s_waitcnt vmcnt(11)
    v_mfma_f32_16x16x32_bf16 v[28:31], v[4:7], v[188:191], v[28:31]
    v_dot2c_f32_bf16 v45, v188, v188
    v_dot2c_f32_bf16 v45, v189, v189
    v_dot2c_f32_bf16 v45, v190, v190
    v_dot2c_f32_bf16 v45, v191, v191
    v_lshl_add_u32 v188, v70, 8, v1
    buffer_load_dwordx4 v[188:191], v188, s[12:15], s27 offen
    s_waitcnt vmcnt(11)
    v_mfma_f32_16x16x32_bf16 v[32:35], v[4:7], v[192:195], v[32:35]
    v_dot2c_f32_bf16 v46, v192, v192
    v_dot2c_f32_bf16 v46, v193, v193
    v_dot2c_f32_bf16 v46, v194, v194
    v_dot2c_f32_bf16 v46, v195, v195
    v_lshl_add_u32 v192, v74, 8, v1
    buffer_load_dwordx4 v[192:195], v192, s[12:15], s27 offen
    s_waitcnt vmcnt(11)
    v_mfma_f32_16x16x32_bf16 v[36:39], v[4:7], v[196:199], v[36:39]
    v_dot2c_f32_bf16 v47, v196, v196
    v_dot2c_f32_bf16 v47, v197, v197
    v_dot2c_f32_bf16 v47, v198, v198
    v_dot2c_f32_bf16 v47, v199, v199
    v_lshl_add_u32 v196, v78, 8, v1
    buffer_load_dwordx4 v[196:199], v196, s[12:15], s27 offen
    s_waitcnt vmcnt(11)
    v_mfma_f32_16x16x32_bf16 v[8:11], v[4:7], v[200:203], v[8:11]
    v_dot2c_f32_bf16 v40, v200, v200
    v_dot2c_f32_bf16 v40, v201, v201
    v_dot2c_f32_bf16 v40, v202, v202
    v_dot2c_f32_bf16 v40, v203, v203
    v_lshl_add_u32 v200, v82, 8, v1
    buffer_load_dwordx4 v[200:203], v200, s[12:15], s27 offen
    s_waitcnt vmcnt(11)
    v_mfma_f32_16x16x32_bf16 v[12:15], v[4:7], v[204:207], v[12:15]
    v_dot2c_f32_bf16 v41, v204, v204
    v_dot2c_f32_bf16 v41, v205, v205
    v_dot2c_f32_bf16 v41, v206, v206
    v_dot2c_f32_bf16 v41, v207, v207
    v_lshl_add_u32 v204, v86, 8, v1
    buffer_load_dwordx4 v[204:207], v204, s[12:15], s27 offen
    s_waitcnt vmcnt(11)
    v_mfma_f32_16x16x32_bf16 v[16:19], v[4:7], v[208:211], v[16:19]
    v_dot2c_f32_bf16 v42, v208, v208
    v_dot2c_f32_bf16 v42, v209, v209
    v_dot2c_f32_bf16 v42, v210, v210
    v_dot2c_f32_bf16 v42, v211, v211
    s_waitcnt lgkmcnt(0)
    ds_read_b128 v[144:147], v3 offset:2592
    ds_read_b128 v[148:151], v3 offset:3232
    ds_read_b128 v[152:155], v3 offset:3872
    ds_read_b128 v[156:159], v3 offset:4512
    ds_read_b32 v160, v3 offset:48
    ds_read_b32 v161, v3 offset:688
    ds_read_b32 v162, v3 offset:1328
    ds_read_b32 v163, v3 offset:1968
    ds_read_b32 v164, v3 offset:2608
    ds_read_b32 v165, v3 offset:3248
    ds_read_b32 v166, v3 offset:3888
    ds_read_b32 v167, v3 offset:4528
    v_lshl_add_u32 v208, v90, 8, v1
    buffer_load_dwordx4 v[208:211], v208, s[12:15], s27 offen
    s_waitcnt vmcnt(11)
    v_mfma_f32_16x16x32_bf16 v[20:23], v[4:7], v[212:215], v[20:23]
    v_dot2c_f32_bf16 v43, v212, v212
    v_dot2c_f32_bf16 v43, v213, v213
    v_dot2c_f32_bf16 v43, v214, v214
    v_dot2c_f32_bf16 v43, v215, v215
    v_lshl_add_u32 v212, v94, 8, v1
    buffer_load_dwordx4 v[212:215], v212, s[12:15], s27 offen
    s_waitcnt vmcnt(11)
    v_mfma_f32_16x16x32_bf16 v[24:27], v[4:7], v[168:171], v[24:27]
    v_dot2c_f32_bf16 v44, v168, v168
    v_dot2c_f32_bf16 v44, v169, v169
    v_dot2c_f32_bf16 v44, v170, v170
    v_dot2c_f32_bf16 v44, v171, v171
    v_lshl_add_u32 v168, v67, 8, v1
    buffer_load_dwordx4 v[168:171], v168, s[12:15], s27 offen
    s_waitcnt vmcnt(11)
    v_mfma_f32_16x16x32_bf16 v[28:31], v[4:7], v[172:175], v[28:31]
    v_dot2c_f32_bf16 v45, v172, v172
    v_dot2c_f32_bf16 v45, v173, v173
    v_dot2c_f32_bf16 v45, v174, v174
    v_dot2c_f32_bf16 v45, v175, v175
    v_lshl_add_u32 v172, v71, 8, v1
    buffer_load_dwordx4 v[172:175], v172, s[12:15], s27 offen
    s_waitcnt vmcnt(11)
    v_mfma_f32_16x16x32_bf16 v[32:35], v[4:7], v[176:179], v[32:35]
    v_dot2c_f32_bf16 v46, v176, v176
    v_dot2c_f32_bf16 v46, v177, v177
    v_dot2c_f32_bf16 v46, v178, v178
    v_dot2c_f32_bf16 v46, v179, v179
    v_lshl_add_u32 v176, v75, 8, v1
    buffer_load_dwordx4 v[176:179], v176, s[12:15], s27 offen
    s_waitcnt vmcnt(11)
    v_mfma_f32_16x16x32_bf16 v[36:39], v[4:7], v[180:183], v[36:39]
    v_dot2c_f32_bf16 v47, v180, v180
    v_dot2c_f32_bf16 v47, v181, v181
    v_dot2c_f32_bf16 v47, v182, v182
    v_dot2c_f32_bf16 v47, v183, v183
    v_lshl_add_u32 v180, v79, 8, v1
    buffer_load_dwordx4 v[180:183], v180, s[12:15], s27 offen
    s_waitcnt vmcnt(11)
    v_mfma_f32_16x16x32_bf16 v[8:11], v[4:7], v[184:187], v[8:11]
    v_dot2c_f32_bf16 v40, v184, v184
    v_dot2c_f32_bf16 v40, v185, v185
    v_dot2c_f32_bf16 v40, v186, v186
    v_dot2c_f32_bf16 v40, v187, v187
    s_waitcnt lgkmcnt(0)
    v_lshl_add_u32 v184, v83, 8, v1
    buffer_load_dwordx4 v[184:187], v184, s[12:15], s27 offen
    s_waitcnt vmcnt(11)
    v_mfma_f32_16x16x32_bf16 v[12:15], v[4:7], v[188:191], v[12:15]
    v_dot2c_f32_bf16 v41, v188, v188
    v_dot2c_f32_bf16 v41, v189, v189
    v_dot2c_f32_bf16 v41, v190, v190
    v_dot2c_f32_bf16 v41, v191, v191
    v_lshl_add_u32 v188, v87, 8, v1
    buffer_load_dwordx4 v[188:191], v188, s[12:15], s27 offen
    s_waitcnt vmcnt(11)
    v_mfma_f32_16x16x32_bf16 v[16:19], v[4:7], v[192:195], v[16:19]
    v_dot2c_f32_bf16 v42, v192, v192
    v_dot2c_f32_bf16 v42, v193, v193
    v_dot2c_f32_bf16 v42, v194, v194
    v_dot2c_f32_bf16 v42, v195, v195
    v_lshl_add_u32 v192, v91, 8, v1
    buffer_load_dwordx4 v[192:195], v192, s[12:15], s27 offen
    s_waitcnt vmcnt(11)
    v_mfma_f32_16x16x32_bf16 v[20:23], v[4:7], v[196:199], v[20:23]
    v_dot2c_f32_bf16 v43, v196, v196
    v_dot2c_f32_bf16 v43, v197, v197
    v_dot2c_f32_bf16 v43, v198, v198
    v_dot2c_f32_bf16 v43, v199, v199
    v_lshl_add_u32 v196, v95, 8, v1
    buffer_load_dwordx4 v[196:199], v196, s[12:15], s27 offen
    s_waitcnt vmcnt(11)
    v_mfma_f32_16x16x32_bf16 v[24:27], v[4:7], v[200:203], v[24:27]
    v_dot2c_f32_bf16 v44, v200, v200
    v_dot2c_f32_bf16 v44, v201, v201
    v_dot2c_f32_bf16 v44, v202, v202
    v_dot2c_f32_bf16 v44, v203, v203
    v_lshl_add_u32 v200, v96, 8, v1
    buffer_load_dwordx4 v[200:203], v200, s[12:15], s27 offen
    s_waitcnt vmcnt(11)
    v_mfma_f32_16x16x32_bf16 v[28:31], v[4:7], v[204:207], v[28:31]
    v_dot2c_f32_bf16 v45, v204, v204
    v_dot2c_f32_bf16 v45, v205, v205
    v_dot2c_f32_bf16 v45, v206, v206
    v_dot2c_f32_bf16 v45, v207, v207
    v_lshl_add_u32 v204, v100, 8, v1
    buffer_load_dwordx4 v[204:207], v204, s[12:15], s27 offen
    s_waitcnt vmcnt(11)
    v_mfma_f32_16x16x32_bf16 v[32:35], v[4:7], v[208:211], v[32:35]
    v_dot2c_f32_bf16 v46, v208, v208
    v_dot2c_f32_bf16 v46, v209, v209
    v_dot2c_f32_bf16 v46, v210, v210
    v_dot2c_f32_bf16 v46, v211, v211
    v_lshl_add_u32 v208, v104, 8, v1
    buffer_load_dwordx4 v[208:211], v208, s[12:15], s27 offen
    s_waitcnt vmcnt(11)
    v_mfma_f32_16x16x32_bf16 v[36:39], v[4:7], v[212:215], v[36:39]
    v_dot2c_f32_bf16 v47, v212, v212
    v_dot2c_f32_bf16 v47, v213, v213
    v_dot2c_f32_bf16 v47, v214, v214
    v_dot2c_f32_bf16 v47, v215, v215
    v_lshl_add_u32 v212, v108, 8, v1
    buffer_load_dwordx4 v[212:215], v212, s[12:15], s27 offen
    s_waitcnt vmcnt(11)
    v_mfma_f32_16x16x32_bf16 v[8:11], v[4:7], v[168:171], v[8:11]
    v_dot2c_f32_bf16 v40, v168, v168
    v_dot2c_f32_bf16 v40, v169, v169
    v_dot2c_f32_bf16 v40, v170, v170
    v_dot2c_f32_bf16 v40, v171, v171
    v_lshl_add_u32 v168, v112, 8, v1
    buffer_load_dwordx4 v[168:171], v168, s[12:15], s27 offen
    s_waitcnt vmcnt(11)
    v_mfma_f32_16x16x32_bf16 v[12:15], v[4:7], v[172:175], v[12:15]
    v_dot2c_f32_bf16 v41, v172, v172
    v_dot2c_f32_bf16 v41, v173, v173
    v_dot2c_f32_bf16 v41, v174, v174
    v_dot2c_f32_bf16 v41, v175, v175
    v_lshl_add_u32 v172, v116, 8, v1
    buffer_load_dwordx4 v[172:175], v172, s[12:15], s27 offen
    s_waitcnt vmcnt(11)
    v_mfma_f32_16x16x32_bf16 v[16:19], v[4:7], v[176:179], v[16:19]
    v_dot2c_f32_bf16 v42, v176, v176
    v_dot2c_f32_bf16 v42, v177, v177
    v_dot2c_f32_bf16 v42, v178, v178
    v_dot2c_f32_bf16 v42, v179, v179
    v_lshl_add_u32 v176, v120, 8, v1
    buffer_load_dwordx4 v[176:179], v176, s[12:15], s27 offen
    s_waitcnt vmcnt(11)
    v_mfma_f32_16x16x32_bf16 v[20:23], v[4:7], v[180:183], v[20:23]
    v_dot2c_f32_bf16 v43, v180, v180
    v_dot2c_f32_bf16 v43, v181, v181
    v_dot2c_f32_bf16 v43, v182, v182
    v_dot2c_f32_bf16 v43, v183, v183
    v_lshl_add_u32 v180, v124, 8, v1
    buffer_load_dwordx4 v[180:183], v180, s[12:15], s27 offen
    s_waitcnt vmcnt(11)
    v_mfma_f32_16x16x32_bf16 v[24:27], v[4:7], v[184:187], v[24:27]
    v_dot2c_f32_bf16 v44, v184, v184
    v_dot2c_f32_bf16 v44, v185, v185
    v_dot2c_f32_bf16 v44, v186, v186
    v_dot2c_f32_bf16 v44, v187, v187
    v_lshl_add_u32 v184, v97, 8, v1
    buffer_load_dwordx4 v[184:187], v184, s[12:15], s27 offen
    s_waitcnt vmcnt(11)
    v_mfma_f32_16x16x32_bf16 v[28:31], v[4:7], v[188:191], v[28:31]
    v_dot2c_f32_bf16 v45, v188, v188
    v_dot2c_f32_bf16 v45, v189, v189
    v_dot2c_f32_bf16 v45, v190, v190
    v_dot2c_f32_bf16 v45, v191, v191
    v_lshl_add_u32 v188, v101, 8, v1
    buffer_load_dwordx4 v[188:191], v188, s[12:15], s27 offen
    s_waitcnt vmcnt(11)
    v_mfma_f32_16x16x32_bf16 v[32:35], v[4:7], v[192:195], v[32:35]
    v_dot2c_f32_bf16 v46, v192, v192
    v_dot2c_f32_bf16 v46, v193, v193
    v_dot2c_f32_bf16 v46, v194, v194
    v_dot2c_f32_bf16 v46, v195, v195
    v_lshl_add_u32 v192, v105, 8, v1
    buffer_load_dwordx4 v[192:195], v192, s[12:15], s27 offen
    s_waitcnt vmcnt(11)
    v_mfma_f32_16x16x32_bf16 v[36:39], v[4:7], v[196:199], v[36:39]
    v_dot2c_f32_bf16 v47, v196, v196
    v_dot2c_f32_bf16 v47, v197, v197
    v_dot2c_f32_bf16 v47, v198, v198
    v_dot2c_f32_bf16 v47, v199, v199
    v_lshl_add_u32 v196, v109, 8, v1
    buffer_load_dwordx4 v[196:199], v196, s[12:15], s27 offen
    s_waitcnt vmcnt(11)
    v_mfma_f32_16x16x32_bf16 v[8:11], v[4:7], v[200:203], v[8:11]
    v_dot2c_f32_bf16 v40, v200, v200
    v_dot2c_f32_bf16 v40, v201, v201
    v_dot2c_f32_bf16 v40, v202, v202
    v_dot2c_f32_bf16 v40, v203, v203
    v_lshl_add_u32 v200, v113, 8, v1
    buffer_load_dwordx4 v[200:203], v200, s[12:15], s27 offen
    s_waitcnt vmcnt(11)
    v_mfma_f32_16x16x32_bf16 v[12:15], v[4:7], v[204:207], v[12:15]
    v_dot2c_f32_bf16 v41, v204, v204
    v_dot2c_f32_bf16 v41, v205, v205
    v_dot2c_f32_bf16 v41, v206, v206
    v_dot2c_f32_bf16 v41, v207, v207
    v_lshl_add_u32 v204, v117, 8, v1
    buffer_load_dwordx4 v[204:207], v204, s[12:15], s27 offen
    s_waitcnt vmcnt(11)
    v_mfma_f32_16x16x32_bf16 v[16:19], v[4:7], v[208:211], v[16:19]
    v_dot2c_f32_bf16 v42, v208, v208
    v_dot2c_f32_bf16 v42, v209, v209
    v_dot2c_f32_bf16 v42, v210, v210
    v_dot2c_f32_bf16 v42, v211, v211
    v_lshl_add_u32 v208, v121, 8, v1
    buffer_load_dwordx4 v[208:211], v208, s[12:15], s27 offen
    s_waitcnt vmcnt(11)
    v_mfma_f32_16x16x32_bf16 v[20:23], v[4:7], v[212:215], v[20:23]
    v_dot2c_f32_bf16 v43, v212, v212
    v_dot2c_f32_bf16 v43, v213, v213
    v_dot2c_f32_bf16 v43, v214, v214
    v_dot2c_f32_bf16 v43, v215, v215
    v_lshl_add_u32 v212, v125, 8, v1
    buffer_load_dwordx4 v[212:215], v212, s[12:15], s27 offen
    s_waitcnt vmcnt(11)
    v_mfma_f32_16x16x32_bf16 v[24:27], v[4:7], v[168:171], v[24:27]
    v_dot2c_f32_bf16 v44, v168, v168
    v_dot2c_f32_bf16 v44, v169, v169
    v_dot2c_f32_bf16 v44, v170, v170
    v_dot2c_f32_bf16 v44, v171, v171
    buffer_load_dword v62, v63, s[36:39], 0 offen sc1
    v_lshl_add_u32 v168, v98, 8, v1
    buffer_load_dwordx4 v[168:171], v168, s[12:15], s27 offen
    s_waitcnt vmcnt(12)
    v_mfma_f32_16x16x32_bf16 v[28:31], v[4:7], v[172:175], v[28:31]
    v_dot2c_f32_bf16 v45, v172, v172
    v_dot2c_f32_bf16 v45, v173, v173
    v_dot2c_f32_bf16 v45, v174, v174
    v_dot2c_f32_bf16 v45, v175, v175
    v_lshl_add_u32 v172, v102, 8, v1
    buffer_load_dwordx4 v[172:175], v172, s[12:15], s27 offen
    s_waitcnt vmcnt(12)
    v_mfma_f32_16x16x32_bf16 v[32:35], v[4:7], v[176:179], v[32:35]
    v_dot2c_f32_bf16 v46, v176, v176
    v_dot2c_f32_bf16 v46, v177, v177
    v_dot2c_f32_bf16 v46, v178, v178
    v_dot2c_f32_bf16 v46, v179, v179
    v_lshl_add_u32 v176, v106, 8, v1
    buffer_load_dwordx4 v[176:179], v176, s[12:15], s27 offen
    s_waitcnt vmcnt(12)
    v_mfma_f32_16x16x32_bf16 v[36:39], v[4:7], v[180:183], v[36:39]
    v_dot2c_f32_bf16 v47, v180, v180
    v_dot2c_f32_bf16 v47, v181, v181
    v_dot2c_f32_bf16 v47, v182, v182
    v_dot2c_f32_bf16 v47, v183, v183
    v_lshl_add_u32 v180, v110, 8, v1
    buffer_load_dwordx4 v[180:183], v180, s[12:15], s27 offen
    s_waitcnt vmcnt(12)
    v_mfma_f32_16x16x32_bf16 v[8:11], v[4:7], v[184:187], v[8:11]
    v_dot2c_f32_bf16 v40, v184, v184
    v_dot2c_f32_bf16 v40, v185, v185
    v_dot2c_f32_bf16 v40, v186, v186
    v_dot2c_f32_bf16 v40, v187, v187
    v_lshl_add_u32 v184, v114, 8, v1
    buffer_load_dwordx4 v[184:187], v184, s[12:15], s27 offen
    s_waitcnt vmcnt(12)
    v_mfma_f32_16x16x32_bf16 v[12:15], v[4:7], v[188:191], v[12:15]
    v_dot2c_f32_bf16 v41, v188, v188
    v_dot2c_f32_bf16 v41, v189, v189
    v_dot2c_f32_bf16 v41, v190, v190
    v_dot2c_f32_bf16 v41, v191, v191
    v_lshl_add_u32 v188, v118, 8, v1
    buffer_load_dwordx4 v[188:191], v188, s[12:15], s27 offen
    s_waitcnt vmcnt(12)
    v_mfma_f32_16x16x32_bf16 v[16:19], v[4:7], v[192:195], v[16:19]
    v_dot2c_f32_bf16 v42, v192, v192
    v_dot2c_f32_bf16 v42, v193, v193
    v_dot2c_f32_bf16 v42, v194, v194
    v_dot2c_f32_bf16 v42, v195, v195
    v_lshl_add_u32 v192, v122, 8, v1
    buffer_load_dwordx4 v[192:195], v192, s[12:15], s27 offen
    s_waitcnt vmcnt(12)
    v_mfma_f32_16x16x32_bf16 v[20:23], v[4:7], v[196:199], v[20:23]
    v_dot2c_f32_bf16 v43, v196, v196
    v_dot2c_f32_bf16 v43, v197, v197
    v_dot2c_f32_bf16 v43, v198, v198
    v_dot2c_f32_bf16 v43, v199, v199
    v_lshl_add_u32 v196, v126, 8, v1
    buffer_load_dwordx4 v[196:199], v196, s[12:15], s27 offen
    s_waitcnt vmcnt(12)
    v_mfma_f32_16x16x32_bf16 v[24:27], v[4:7], v[200:203], v[24:27]
    v_dot2c_f32_bf16 v44, v200, v200
    v_dot2c_f32_bf16 v44, v201, v201
    v_dot2c_f32_bf16 v44, v202, v202
    v_dot2c_f32_bf16 v44, v203, v203
    v_lshl_add_u32 v200, v99, 8, v1
    buffer_load_dwordx4 v[200:203], v200, s[12:15], s27 offen
    s_waitcnt vmcnt(12)
    v_mfma_f32_16x16x32_bf16 v[28:31], v[4:7], v[204:207], v[28:31]
    v_dot2c_f32_bf16 v45, v204, v204
    v_dot2c_f32_bf16 v45, v205, v205
    v_dot2c_f32_bf16 v45, v206, v206
    v_dot2c_f32_bf16 v45, v207, v207
    v_lshl_add_u32 v204, v103, 8, v1
    buffer_load_dwordx4 v[204:207], v204, s[12:15], s27 offen
    s_waitcnt vmcnt(12)
    v_mfma_f32_16x16x32_bf16 v[32:35], v[4:7], v[208:211], v[32:35]
    v_dot2c_f32_bf16 v46, v208, v208
    v_dot2c_f32_bf16 v46, v209, v209
    v_dot2c_f32_bf16 v46, v210, v210
    v_dot2c_f32_bf16 v46, v211, v211
    v_lshl_add_u32 v208, v107, 8, v1
    buffer_load_dwordx4 v[208:211], v208, s[12:15], s27 offen
    s_waitcnt vmcnt(12)
    v_mfma_f32_16x16x32_bf16 v[36:39], v[4:7], v[212:215], v[36:39]
    v_dot2c_f32_bf16 v47, v212, v212
    v_dot2c_f32_bf16 v47, v213, v213
    v_dot2c_f32_bf16 v47, v214, v214
    v_dot2c_f32_bf16 v47, v215, v215
    v_lshl_add_u32 v212, v111, 8, v1
    buffer_load_dwordx4 v[212:215], v212, s[12:15], s27 offen
    s_waitcnt vmcnt(11)
    v_mfma_f32_16x16x32_bf16 v[8:11], v[4:7], v[168:171], v[8:11]
    v_dot2c_f32_bf16 v40, v168, v168
    v_dot2c_f32_bf16 v40, v169, v169
    v_dot2c_f32_bf16 v40, v170, v170
    v_dot2c_f32_bf16 v40, v171, v171
    v_lshl_add_u32 v168, v115, 8, v1
    buffer_load_dwordx4 v[168:171], v168, s[12:15], s27 offen
    s_waitcnt vmcnt(11)
    v_mfma_f32_16x16x32_bf16 v[12:15], v[4:7], v[172:175], v[12:15]
    v_dot2c_f32_bf16 v41, v172, v172
    v_dot2c_f32_bf16 v41, v173, v173
    v_dot2c_f32_bf16 v41, v174, v174
    v_dot2c_f32_bf16 v41, v175, v175
    v_lshl_add_u32 v172, v119, 8, v1
    buffer_load_dwordx4 v[172:175], v172, s[12:15], s27 offen
    s_waitcnt vmcnt(11)
    v_mfma_f32_16x16x32_bf16 v[16:19], v[4:7], v[176:179], v[16:19]
    v_dot2c_f32_bf16 v42, v176, v176
    v_dot2c_f32_bf16 v42, v177, v177
    v_dot2c_f32_bf16 v42, v178, v178
    v_dot2c_f32_bf16 v42, v179, v179
    v_lshl_add_u32 v176, v123, 8, v1
    buffer_load_dwordx4 v[176:179], v176, s[12:15], s27 offen
    s_waitcnt vmcnt(11)
    v_mfma_f32_16x16x32_bf16 v[20:23], v[4:7], v[180:183], v[20:23]
    v_dot2c_f32_bf16 v43, v180, v180
    v_dot2c_f32_bf16 v43, v181, v181
    v_dot2c_f32_bf16 v43, v182, v182
    v_dot2c_f32_bf16 v43, v183, v183
    v_lshl_add_u32 v180, v127, 8, v1
    buffer_load_dwordx4 v[180:183], v180, s[12:15], s27 offen
    s_waitcnt vmcnt(11)
    v_mfma_f32_16x16x32_bf16 v[24:27], v[4:7], v[184:187], v[24:27]
    v_dot2c_f32_bf16 v44, v184, v184
    v_dot2c_f32_bf16 v44, v185, v185
    v_dot2c_f32_bf16 v44, v186, v186
    v_dot2c_f32_bf16 v44, v187, v187
    v_lshl_add_u32 v184, v128, 8, v1
    buffer_load_dwordx4 v[184:187], v184, s[12:15], s27 offen
    s_waitcnt vmcnt(11)
    v_mfma_f32_16x16x32_bf16 v[28:31], v[4:7], v[188:191], v[28:31]
    v_dot2c_f32_bf16 v45, v188, v188
    v_dot2c_f32_bf16 v45, v189, v189
    v_dot2c_f32_bf16 v45, v190, v190
    v_dot2c_f32_bf16 v45, v191, v191
    v_lshl_add_u32 v188, v132, 8, v1
    buffer_load_dwordx4 v[188:191], v188, s[12:15], s27 offen
    s_waitcnt vmcnt(11)
    v_mfma_f32_16x16x32_bf16 v[32:35], v[4:7], v[192:195], v[32:35]
    v_dot2c_f32_bf16 v46, v192, v192
    v_dot2c_f32_bf16 v46, v193, v193
    v_dot2c_f32_bf16 v46, v194, v194
    v_dot2c_f32_bf16 v46, v195, v195
    v_lshl_add_u32 v192, v136, 8, v1
    buffer_load_dwordx4 v[192:195], v192, s[12:15], s27 offen
    s_waitcnt vmcnt(11)
    v_mfma_f32_16x16x32_bf16 v[36:39], v[4:7], v[196:199], v[36:39]
    v_dot2c_f32_bf16 v47, v196, v196
    v_dot2c_f32_bf16 v47, v197, v197
    v_dot2c_f32_bf16 v47, v198, v198
    v_dot2c_f32_bf16 v47, v199, v199
    v_lshl_add_u32 v196, v140, 8, v1
    buffer_load_dwordx4 v[196:199], v196, s[12:15], s27 offen
    s_waitcnt vmcnt(11)
    v_mfma_f32_16x16x32_bf16 v[8:11], v[4:7], v[200:203], v[8:11]
    v_dot2c_f32_bf16 v40, v200, v200
    v_dot2c_f32_bf16 v40, v201, v201
    v_dot2c_f32_bf16 v40, v202, v202
    v_dot2c_f32_bf16 v40, v203, v203
    v_lshl_add_u32 v200, v144, 8, v1
    buffer_load_dwordx4 v[200:203], v200, s[12:15], s27 offen
    s_waitcnt vmcnt(11)
    v_mfma_f32_16x16x32_bf16 v[12:15], v[4:7], v[204:207], v[12:15]
    v_dot2c_f32_bf16 v41, v204, v204
    v_dot2c_f32_bf16 v41, v205, v205
    v_dot2c_f32_bf16 v41, v206, v206
    v_dot2c_f32_bf16 v41, v207, v207
    v_lshl_add_u32 v204, v148, 8, v1
    buffer_load_dwordx4 v[204:207], v204, s[12:15], s27 offen
    s_waitcnt vmcnt(11)
    v_mfma_f32_16x16x32_bf16 v[16:19], v[4:7], v[208:211], v[16:19]
    v_dot2c_f32_bf16 v42, v208, v208
    v_dot2c_f32_bf16 v42, v209, v209
    v_dot2c_f32_bf16 v42, v210, v210
    v_dot2c_f32_bf16 v42, v211, v211
    v_lshl_add_u32 v208, v152, 8, v1
    buffer_load_dwordx4 v[208:211], v208, s[12:15], s27 offen
    s_waitcnt vmcnt(11)
    v_mfma_f32_16x16x32_bf16 v[20:23], v[4:7], v[212:215], v[20:23]
    v_dot2c_f32_bf16 v43, v212, v212
    v_dot2c_f32_bf16 v43, v213, v213
    v_dot2c_f32_bf16 v43, v214, v214
    v_dot2c_f32_bf16 v43, v215, v215
    v_lshl_add_u32 v212, v156, 8, v1
    buffer_load_dwordx4 v[212:215], v212, s[12:15], s27 offen
    s_waitcnt vmcnt(11)
    v_mfma_f32_16x16x32_bf16 v[24:27], v[4:7], v[168:171], v[24:27]
    v_dot2c_f32_bf16 v44, v168, v168
    v_dot2c_f32_bf16 v44, v169, v169
    v_dot2c_f32_bf16 v44, v170, v170
    v_dot2c_f32_bf16 v44, v171, v171
    v_lshl_add_u32 v168, v129, 8, v1
    buffer_load_dwordx4 v[168:171], v168, s[12:15], s27 offen
    s_waitcnt vmcnt(11)
    v_mfma_f32_16x16x32_bf16 v[28:31], v[4:7], v[172:175], v[28:31]
    v_dot2c_f32_bf16 v45, v172, v172
    v_dot2c_f32_bf16 v45, v173, v173
    v_dot2c_f32_bf16 v45, v174, v174
    v_dot2c_f32_bf16 v45, v175, v175
    v_lshl_add_u32 v172, v133, 8, v1
    buffer_load_dwordx4 v[172:175], v172, s[12:15], s27 offen
    s_waitcnt vmcnt(11)
    v_mfma_f32_16x16x32_bf16 v[32:35], v[4:7], v[176:179], v[32:35]
    v_dot2c_f32_bf16 v46, v176, v176
    v_dot2c_f32_bf16 v46, v177, v177
    v_dot2c_f32_bf16 v46, v178, v178
    v_dot2c_f32_bf16 v46, v179, v179
    v_lshl_add_u32 v176, v137, 8, v1
    buffer_load_dwordx4 v[176:179], v176, s[12:15], s27 offen
    s_waitcnt vmcnt(11)
    v_mfma_f32_16x16x32_bf16 v[36:39], v[4:7], v[180:183], v[36:39]
    v_dot2c_f32_bf16 v47, v180, v180
    v_dot2c_f32_bf16 v47, v181, v181
    v_dot2c_f32_bf16 v47, v182, v182
    v_dot2c_f32_bf16 v47, v183, v183
    v_lshl_add_u32 v180, v141, 8, v1
    buffer_load_dwordx4 v[180:183], v180, s[12:15], s27 offen
    s_waitcnt vmcnt(11)
    v_mfma_f32_16x16x32_bf16 v[8:11], v[4:7], v[184:187], v[8:11]
    v_dot2c_f32_bf16 v40, v184, v184
    v_dot2c_f32_bf16 v40, v185, v185
    v_dot2c_f32_bf16 v40, v186, v186
    v_dot2c_f32_bf16 v40, v187, v187
    v_lshl_add_u32 v184, v145, 8, v1
    buffer_load_dwordx4 v[184:187], v184, s[12:15], s27 offen
    s_waitcnt vmcnt(11)
    v_mfma_f32_16x16x32_bf16 v[12:15], v[4:7], v[188:191], v[12:15]
    v_dot2c_f32_bf16 v41, v188, v188
    v_dot2c_f32_bf16 v41, v189, v189
    v_dot2c_f32_bf16 v41, v190, v190
    v_dot2c_f32_bf16 v41, v191, v191
    v_lshl_add_u32 v188, v149, 8, v1
    buffer_load_dwordx4 v[188:191], v188, s[12:15], s27 offen
    s_waitcnt vmcnt(11)
    v_mfma_f32_16x16x32_bf16 v[16:19], v[4:7], v[192:195], v[16:19]
    v_dot2c_f32_bf16 v42, v192, v192
    v_dot2c_f32_bf16 v42, v193, v193
    v_dot2c_f32_bf16 v42, v194, v194
    v_dot2c_f32_bf16 v42, v195, v195
    v_lshl_add_u32 v192, v153, 8, v1
    buffer_load_dwordx4 v[192:195], v192, s[12:15], s27 offen
    s_waitcnt vmcnt(11)
    v_mfma_f32_16x16x32_bf16 v[20:23], v[4:7], v[196:199], v[20:23]
    v_dot2c_f32_bf16 v43, v196, v196
    v_dot2c_f32_bf16 v43, v197, v197
    v_dot2c_f32_bf16 v43, v198, v198
    v_dot2c_f32_bf16 v43, v199, v199
    v_lshl_add_u32 v196, v157, 8, v1
    buffer_load_dwordx4 v[196:199], v196, s[12:15], s27 offen
    s_waitcnt vmcnt(11)
    v_mfma_f32_16x16x32_bf16 v[24:27], v[4:7], v[200:203], v[24:27]
    v_dot2c_f32_bf16 v44, v200, v200
    v_dot2c_f32_bf16 v44, v201, v201
    v_dot2c_f32_bf16 v44, v202, v202
    v_dot2c_f32_bf16 v44, v203, v203
    v_lshl_add_u32 v200, v130, 8, v1
    buffer_load_dwordx4 v[200:203], v200, s[12:15], s27 offen
    s_waitcnt vmcnt(11)
    v_mfma_f32_16x16x32_bf16 v[28:31], v[4:7], v[204:207], v[28:31]
    v_dot2c_f32_bf16 v45, v204, v204
    v_dot2c_f32_bf16 v45, v205, v205
    v_dot2c_f32_bf16 v45, v206, v206
    v_dot2c_f32_bf16 v45, v207, v207
    v_lshl_add_u32 v204, v134, 8, v1
    buffer_load_dwordx4 v[204:207], v204, s[12:15], s27 offen
    s_waitcnt vmcnt(11)
    v_mfma_f32_16x16x32_bf16 v[32:35], v[4:7], v[208:211], v[32:35]
    v_dot2c_f32_bf16 v46, v208, v208
    v_dot2c_f32_bf16 v46, v209, v209
    v_dot2c_f32_bf16 v46, v210, v210
    v_dot2c_f32_bf16 v46, v211, v211
    v_lshl_add_u32 v208, v138, 8, v1
    buffer_load_dwordx4 v[208:211], v208, s[12:15], s27 offen
    s_waitcnt vmcnt(11)
    v_mfma_f32_16x16x32_bf16 v[36:39], v[4:7], v[212:215], v[36:39]
    v_dot2c_f32_bf16 v47, v212, v212
    v_dot2c_f32_bf16 v47, v213, v213
    v_dot2c_f32_bf16 v47, v214, v214
    v_dot2c_f32_bf16 v47, v215, v215
    v_lshl_add_u32 v212, v142, 8, v1
    buffer_load_dwordx4 v[212:215], v212, s[12:15], s27 offen
    s_waitcnt vmcnt(11)
    v_mfma_f32_16x16x32_bf16 v[8:11], v[4:7], v[168:171], v[8:11]
    v_dot2c_f32_bf16 v40, v168, v168
    v_dot2c_f32_bf16 v40, v169, v169
    v_dot2c_f32_bf16 v40, v170, v170
    v_dot2c_f32_bf16 v40, v171, v171
    v_lshl_add_u32 v168, v146, 8, v1
    buffer_load_dwordx4 v[168:171], v168, s[12:15], s27 offen
    s_waitcnt vmcnt(11)
    v_mfma_f32_16x16x32_bf16 v[12:15], v[4:7], v[172:175], v[12:15]
    v_dot2c_f32_bf16 v41, v172, v172
    v_dot2c_f32_bf16 v41, v173, v173
    v_dot2c_f32_bf16 v41, v174, v174
    v_dot2c_f32_bf16 v41, v175, v175
    v_lshl_add_u32 v172, v150, 8, v1
    buffer_load_dwordx4 v[172:175], v172, s[12:15], s27 offen
    s_waitcnt vmcnt(11)
    v_mfma_f32_16x16x32_bf16 v[16:19], v[4:7], v[176:179], v[16:19]
    v_dot2c_f32_bf16 v42, v176, v176
    v_dot2c_f32_bf16 v42, v177, v177
    v_dot2c_f32_bf16 v42, v178, v178
    v_dot2c_f32_bf16 v42, v179, v179
    v_lshl_add_u32 v176, v154, 8, v1
    buffer_load_dwordx4 v[176:179], v176, s[12:15], s27 offen
    s_waitcnt vmcnt(11)
    v_mfma_f32_16x16x32_bf16 v[20:23], v[4:7], v[180:183], v[20:23]
    v_dot2c_f32_bf16 v43, v180, v180
    v_dot2c_f32_bf16 v43, v181, v181
    v_dot2c_f32_bf16 v43, v182, v182
    v_dot2c_f32_bf16 v43, v183, v183
    v_lshl_add_u32 v180, v158, 8, v1
    buffer_load_dwordx4 v[180:183], v180, s[12:15], s27 offen
    s_waitcnt vmcnt(11)
    v_mfma_f32_16x16x32_bf16 v[24:27], v[4:7], v[184:187], v[24:27]
    v_dot2c_f32_bf16 v44, v184, v184
    v_dot2c_f32_bf16 v44, v185, v185
    v_dot2c_f32_bf16 v44, v186, v186
    v_dot2c_f32_bf16 v44, v187, v187
    v_lshl_add_u32 v184, v131, 8, v1
    buffer_load_dwordx4 v[184:187], v184, s[12:15], s27 offen
    s_waitcnt vmcnt(11)
    v_mfma_f32_16x16x32_bf16 v[28:31], v[4:7], v[188:191], v[28:31]
    v_dot2c_f32_bf16 v45, v188, v188
    v_dot2c_f32_bf16 v45, v189, v189
    v_dot2c_f32_bf16 v45, v190, v190
    v_dot2c_f32_bf16 v45, v191, v191
    v_lshl_add_u32 v188, v135, 8, v1
    buffer_load_dwordx4 v[188:191], v188, s[12:15], s27 offen
    s_waitcnt vmcnt(11)
    v_mfma_f32_16x16x32_bf16 v[32:35], v[4:7], v[192:195], v[32:35]
    v_dot2c_f32_bf16 v46, v192, v192
    v_dot2c_f32_bf16 v46, v193, v193
    v_dot2c_f32_bf16 v46, v194, v194
    v_dot2c_f32_bf16 v46, v195, v195
    v_lshl_add_u32 v192, v139, 8, v1
    buffer_load_dwordx4 v[192:195], v192, s[12:15], s27 offen
    s_waitcnt vmcnt(11)
    v_mfma_f32_16x16x32_bf16 v[36:39], v[4:7], v[196:199], v[36:39]
    v_dot2c_f32_bf16 v47, v196, v196
    v_dot2c_f32_bf16 v47, v197, v197
    v_dot2c_f32_bf16 v47, v198, v198
    v_dot2c_f32_bf16 v47, v199, v199
    v_lshl_add_u32 v196, v143, 8, v1
    buffer_load_dwordx4 v[196:199], v196, s[12:15], s27 offen
    s_waitcnt vmcnt(11)
    v_mfma_f32_16x16x32_bf16 v[8:11], v[4:7], v[200:203], v[8:11]
    v_dot2c_f32_bf16 v40, v200, v200
    v_dot2c_f32_bf16 v40, v201, v201
    v_dot2c_f32_bf16 v40, v202, v202
    v_dot2c_f32_bf16 v40, v203, v203
    v_lshl_add_u32 v200, v147, 8, v1
    buffer_load_dwordx4 v[200:203], v200, s[12:15], s27 offen
    s_waitcnt vmcnt(11)
    v_mfma_f32_16x16x32_bf16 v[12:15], v[4:7], v[204:207], v[12:15]
    v_dot2c_f32_bf16 v41, v204, v204
    v_dot2c_f32_bf16 v41, v205, v205
    v_dot2c_f32_bf16 v41, v206, v206
    v_dot2c_f32_bf16 v41, v207, v207
    v_lshl_add_u32 v204, v151, 8, v1
    buffer_load_dwordx4 v[204:207], v204, s[12:15], s27 offen
    s_waitcnt vmcnt(11)
    v_mfma_f32_16x16x32_bf16 v[16:19], v[4:7], v[208:211], v[16:19]
    v_dot2c_f32_bf16 v42, v208, v208
    v_dot2c_f32_bf16 v42, v209, v209
    v_dot2c_f32_bf16 v42, v210, v210
    v_dot2c_f32_bf16 v42, v211, v211
    v_lshl_add_u32 v208, v155, 8, v1
    buffer_load_dwordx4 v[208:211], v208, s[12:15], s27 offen
    s_waitcnt vmcnt(11)
    v_mfma_f32_16x16x32_bf16 v[20:23], v[4:7], v[212:215], v[20:23]
    v_dot2c_f32_bf16 v43, v212, v212
    v_dot2c_f32_bf16 v43, v213, v213
    v_dot2c_f32_bf16 v43, v214, v214
    v_dot2c_f32_bf16 v43, v215, v215
    v_lshl_add_u32 v212, v159, 8, v1
    buffer_load_dwordx4 v[212:215], v212, s[12:15], s27 offen
    s_waitcnt vmcnt(11)
    v_mfma_f32_16x16x32_bf16 v[24:27], v[4:7], v[168:171], v[24:27]
    v_dot2c_f32_bf16 v44, v168, v168
    v_dot2c_f32_bf16 v44, v169, v169
    v_dot2c_f32_bf16 v44, v170, v170
    v_dot2c_f32_bf16 v44, v171, v171
    v_lshl_add_u32 v168, v160, 8, v1
    buffer_load_dwordx4 v[168:171], v168, s[12:15], s27 offen
    s_waitcnt vmcnt(11)
    v_mfma_f32_16x16x32_bf16 v[28:31], v[4:7], v[172:175], v[28:31]
    v_dot2c_f32_bf16 v45, v172, v172
    v_dot2c_f32_bf16 v45, v173, v173
    v_dot2c_f32_bf16 v45, v174, v174
    v_dot2c_f32_bf16 v45, v175, v175
    v_lshl_add_u32 v172, v161, 8, v1
    buffer_load_dwordx4 v[172:175], v172, s[12:15], s27 offen
    s_waitcnt vmcnt(11)
    v_mfma_f32_16x16x32_bf16 v[32:35], v[4:7], v[176:179], v[32:35]
    v_dot2c_f32_bf16 v46, v176, v176
    v_dot2c_f32_bf16 v46, v177, v177
    v_dot2c_f32_bf16 v46, v178, v178
    v_dot2c_f32_bf16 v46, v179, v179
    v_lshl_add_u32 v176, v162, 8, v1
    buffer_load_dwordx4 v[176:179], v176, s[12:15], s27 offen
    s_waitcnt vmcnt(11)
    v_mfma_f32_16x16x32_bf16 v[36:39], v[4:7], v[180:183], v[36:39]
    v_dot2c_f32_bf16 v47, v180, v180
    v_dot2c_f32_bf16 v47, v181, v181
    v_dot2c_f32_bf16 v47, v182, v182
    v_dot2c_f32_bf16 v47, v183, v183
    v_lshl_add_u32 v180, v163, 8, v1
    buffer_load_dwordx4 v[180:183], v180, s[12:15], s27 offen
    s_waitcnt vmcnt(11)
    v_mfma_f32_16x16x32_bf16 v[8:11], v[4:7], v[184:187], v[8:11]
    v_dot2c_f32_bf16 v40, v184, v184
    v_dot2c_f32_bf16 v40, v185, v185
    v_dot2c_f32_bf16 v40, v186, v186
    v_dot2c_f32_bf16 v40, v187, v187
    v_lshl_add_u32 v184, v164, 8, v1
    buffer_load_dwordx4 v[184:187], v184, s[12:15], s27 offen
    s_waitcnt vmcnt(11)
    v_mfma_f32_16x16x32_bf16 v[12:15], v[4:7], v[188:191], v[12:15]
    v_dot2c_f32_bf16 v41, v188, v188
    v_dot2c_f32_bf16 v41, v189, v189
    v_dot2c_f32_bf16 v41, v190, v190
    v_dot2c_f32_bf16 v41, v191, v191
    v_lshl_add_u32 v188, v165, 8, v1
    buffer_load_dwordx4 v[188:191], v188, s[12:15], s27 offen
    s_waitcnt vmcnt(11)
    v_mfma_f32_16x16x32_bf16 v[16:19], v[4:7], v[192:195], v[16:19]
    v_dot2c_f32_bf16 v42, v192, v192
    v_dot2c_f32_bf16 v42, v193, v193
    v_dot2c_f32_bf16 v42, v194, v194
    v_dot2c_f32_bf16 v42, v195, v195
    v_lshl_add_u32 v192, v166, 8, v1
    buffer_load_dwordx4 v[192:195], v192, s[12:15], s27 offen
    s_waitcnt vmcnt(11)
    v_mfma_f32_16x16x32_bf16 v[20:23], v[4:7], v[196:199], v[20:23]
    v_dot2c_f32_bf16 v43, v196, v196
    v_dot2c_f32_bf16 v43, v197, v197
    v_dot2c_f32_bf16 v43, v198, v198
    v_dot2c_f32_bf16 v43, v199, v199
    v_lshl_add_u32 v196, v167, 8, v1
    buffer_load_dwordx4 v[196:199], v196, s[12:15], s27 offen
    s_waitcnt vmcnt(11)
    v_mfma_f32_16x16x32_bf16 v[24:27], v[4:7], v[200:203], v[24:27]
    v_dot2c_f32_bf16 v44, v200, v200
    v_dot2c_f32_bf16 v44, v201, v201
    v_dot2c_f32_bf16 v44, v202, v202
    v_dot2c_f32_bf16 v44, v203, v203
    v_bfe_u32 v2, v0, 4, 1
    v_bfe_u32 v3, v0, 2, 1
    v_lshl_add_u32 v2, v3, 1, v2
    v_and_b32 v3, 1, v0
    v_lshl_add_u32 v2, v3, 2, v2
    v_bfe_u32 v3, v0, 5, 1
    v_lshl_add_u32 v2, v2, 1, v3
    v_bfe_u32 v3, v0, 3, 1
    v_lshl_add_u32 v2, v2, 1, v3
    v_lshlrev_b32 v3, 3, v2
    v_lshlrev_b32 v2, 1, v2
    v_readfirstlane_b32 s42, v62
    s_and_b32 s21, s21, 0xffff
    s_mov_b32 s22, 131072
    s_mov_b32 s23, 0x00020000
    s_and_b32 s17, s17, 0xffff
    s_mov_b32 s18, 32768
    s_mov_b32 s19, 0x00020000
    s_lshl_b32 s26, s25, 8
    s_lshl_b32 s28, s25, 6
    s_mov_b32 s29, 0xffffff00
    v_and_b32 v1, 1, v0
    v_cmp_eq_u32 s[30:31], 1, v1
    v_and_b32 v1, 2, v0
    v_cmp_eq_u32 s[32:33], 0, v1
    s_waitcnt vmcnt(10)
    v_mfma_f32_16x16x32_bf16 v[28:31], v[4:7], v[204:207], v[28:31]
    v_dot2c_f32_bf16 v45, v204, v204
    v_dot2c_f32_bf16 v45, v205, v205
    v_dot2c_f32_bf16 v45, v206, v206
    v_dot2c_f32_bf16 v45, v207, v207
    s_waitcnt vmcnt(9)
    v_mfma_f32_16x16x32_bf16 v[32:35], v[4:7], v[208:211], v[32:35]
    v_dot2c_f32_bf16 v46, v208, v208
    v_dot2c_f32_bf16 v46, v209, v209
    v_dot2c_f32_bf16 v46, v210, v210
    v_dot2c_f32_bf16 v46, v211, v211
    s_waitcnt vmcnt(8)
    v_mfma_f32_16x16x32_bf16 v[36:39], v[4:7], v[212:215], v[36:39]
    v_dot2c_f32_bf16 v47, v212, v212
    v_dot2c_f32_bf16 v47, v213, v213
    v_dot2c_f32_bf16 v47, v214, v214
    v_dot2c_f32_bf16 v47, v215, v215
    s_waitcnt vmcnt(7)
    v_mfma_f32_16x16x32_bf16 v[8:11], v[4:7], v[168:171], v[8:11]
    v_dot2c_f32_bf16 v40, v168, v168
    v_dot2c_f32_bf16 v40, v169, v169
    v_dot2c_f32_bf16 v40, v170, v170
    v_dot2c_f32_bf16 v40, v171, v171
    s_waitcnt vmcnt(6)
    v_mfma_f32_16x16x32_bf16 v[12:15], v[4:7], v[172:175], v[12:15]
    v_dot2c_f32_bf16 v41, v172, v172
    v_dot2c_f32_bf16 v41, v173, v173
    v_dot2c_f32_bf16 v41, v174, v174
    v_dot2c_f32_bf16 v41, v175, v175
    s_waitcnt vmcnt(5)
    v_mfma_f32_16x16x32_bf16 v[16:19], v[4:7], v[176:179], v[16:19]
    v_dot2c_f32_bf16 v42, v176, v176
    v_dot2c_f32_bf16 v42, v177, v177
    v_dot2c_f32_bf16 v42, v178, v178
    v_dot2c_f32_bf16 v42, v179, v179
    v_fma_f32 v64, v8, v8, -v40
    v_fmac_f32 v64, v9, v9
    v_fmac_f32 v64, v10, v10
    v_fmac_f32 v64, v11, v11
    s_waitcnt vmcnt(4)
    v_mfma_f32_16x16x32_bf16 v[20:23], v[4:7], v[180:183], v[20:23]
    v_dot2c_f32_bf16 v43, v180, v180
    v_dot2c_f32_bf16 v43, v181, v181
    v_dot2c_f32_bf16 v43, v182, v182
    v_dot2c_f32_bf16 v43, v183, v183
    v_fma_f32 v65, v12, v12, -v41
    v_fmac_f32 v65, v13, v13
    v_fmac_f32 v65, v14, v14
    v_fmac_f32 v65, v15, v15
    s_waitcnt vmcnt(3)
    v_mfma_f32_16x16x32_bf16 v[24:27], v[4:7], v[184:187], v[24:27]
    v_dot2c_f32_bf16 v44, v184, v184
    v_dot2c_f32_bf16 v44, v185, v185
    v_dot2c_f32_bf16 v44, v186, v186
    v_dot2c_f32_bf16 v44, v187, v187
    v_fma_f32 v66, v16, v16, -v42
    v_fmac_f32 v66, v17, v17
    v_fmac_f32 v66, v18, v18
    v_fmac_f32 v66, v19, v19
    s_waitcnt vmcnt(2)
    v_mfma_f32_16x16x32_bf16 v[28:31], v[4:7], v[188:191], v[28:31]
    v_dot2c_f32_bf16 v45, v188, v188
    v_dot2c_f32_bf16 v45, v189, v189
    v_dot2c_f32_bf16 v45, v190, v190
    v_dot2c_f32_bf16 v45, v191, v191
    v_fma_f32 v67, v20, v20, -v43
    v_fmac_f32 v67, v21, v21
    v_fmac_f32 v67, v22, v22
    v_fmac_f32 v67, v23, v23
    s_waitcnt vmcnt(1)
    v_mfma_f32_16x16x32_bf16 v[32:35], v[4:7], v[192:195], v[32:35]
    v_dot2c_f32_bf16 v46, v192, v192
    v_dot2c_f32_bf16 v46, v193, v193
    v_dot2c_f32_bf16 v46, v194, v194
    v_dot2c_f32_bf16 v46, v195, v195
    v_fma_f32 v68, v24, v24, -v44
    v_fmac_f32 v68, v25, v25
    v_fmac_f32 v68, v26, v26
    v_fmac_f32 v68, v27, v27
    s_waitcnt vmcnt(0)
    v_mfma_f32_16x16x32_bf16 v[36:39], v[4:7], v[196:199], v[36:39]
    v_dot2c_f32_bf16 v47, v196, v196
    v_dot2c_f32_bf16 v47, v197, v197
    v_dot2c_f32_bf16 v47, v198, v198
    v_dot2c_f32_bf16 v47, v199, v199
    v_fma_f32 v69, v28, v28, -v45
    v_fmac_f32 v69, v29, v29
    v_fmac_f32 v69, v30, v30
    v_fmac_f32 v69, v31, v31
    s_cmp_lg_u32 s42, 0
    s_cbranch_scc1 L_have_nonce
    s_memrealtime s[40:41]
    s_waitcnt lgkmcnt(0)
    s_or_b32 s40, s40, 1
    v_mov_b32 v62, s40
    s_mov_b64 exec, 1
    buffer_atomic_cmpswap v[62:63], v63, s[36:39], 0 offen sc0
    s_waitcnt vmcnt(0)
    v_readfirstlane_b32 s42, v62
    s_mov_b64 exec, -1
    s_nop 3
    s_cmp_eq_u32 s42, 0
    s_cselect_b32 s42, s40, s42
L_have_nonce:
    s_nop 7
    v_fma_f32 v70, v32, v32, -v46
    v_fma_f32 v71, v36, v36, -v47
    v_fmac_f32 v70, v33, v33
    v_fmac_f32 v71, v37, v37
    v_fmac_f32 v70, v34, v34
    v_fmac_f32 v71, v38, v38
    v_fmac_f32 v70, v35, v35
    v_fmac_f32 v71, v39, v39
    s_nop 1
    v_permlane16_swap_b32 v64, v65
    v_permlane16_swap_b32 v66, v67
    v_permlane16_swap_b32 v68, v69
    v_permlane16_swap_b32 v70, v71
    s_nop 1
    v_add_f32 v72, v64, v65
    v_add_f32 v73, v66, v67
    v_add_f32 v74, v68, v69
    v_add_f32 v75, v70, v71
    s_nop 1
    v_add_f32_dpp v76, v72, v72 row_half_mirror row_mask:0xf bank_mask:0x5
    v_add_f32_dpp v76, v73, v73 row_half_mirror row_mask:0xf bank_mask:0xa
    v_add_f32_dpp v77, v74, v74 row_half_mirror row_mask:0xf bank_mask:0x5
    v_add_f32_dpp v77, v75, v75 row_half_mirror row_mask:0xf bank_mask:0xa
    s_nop 1
    v_add_f32_dpp v76, v76, v76 quad_perm:[1,0,3,2] row_mask:0xf bank_mask:0xf
    v_add_f32_dpp v77, v77, v77 quad_perm:[1,0,3,2] row_mask:0xf bank_mask:0xf
    s_nop 1
    v_add_f32_dpp v76, v76, v76 quad_perm:[2,3,0,1] row_mask:0xf bank_mask:0xf
    v_add_f32_dpp v77, v77, v77 quad_perm:[2,3,0,1] row_mask:0xf bank_mask:0xf
    v_mov_b32 v80, s42
    v_cndmask_b32 v76, v76, v77, s[30:31]
    v_and_b32 v76, s29, v76
    v_or_b32 v81, 0xa7, v76
    s_mov_b64 exec, s[32:33]
    buffer_atomic_swap_x2 v[80:81], v3, s[20:23], s26 offen sc0
    s_waitcnt vmcnt(0)
    v_cmp_eq_u32 vcc, s42, v80
    v_and_b32 v82, 0xff, v81
    v_and_b32 v81, s29, v81
    s_and_b64 exec, exec, vcc
    v_cmp_eq_u32 vcc, 0xa7, v82
    v_add_f32 v76, v76, v81
    s_and_b64 exec, exec, vcc
    s_cbranch_execz L_done
    v_mul_f32 v76, 0.5, v76
    v_cvt_pk_bf16_f32 v76, v76, v76
    buffer_store_short v76, v2, s[16:19], s28 offen
L_done:
    s_endpgm
.section .rodata,"a"
.p2align 6
.amdhsa_kernel standalone__fm_second_order__recsys_kernel
  .amdhsa_next_free_vgpr 216
  .amdhsa_next_free_sgpr 48
  .amdhsa_accum_offset 216
  .amdhsa_group_segment_fixed_size 0
  .amdhsa_kernarg_size 40
  .amdhsa_user_sgpr_count 2
  .amdhsa_user_sgpr_kernarg_segment_ptr 1
  .amdhsa_system_sgpr_workgroup_id_x 1
.end_amdhsa_kernel
```
